```python
import torch

def _softmax(x, axis=-1):
    return torch.softmax(x, dim=axis)
def _gelu(x):
    return torch.nn.functional.gelu(x, approximate="tanh")
def _silu(x):
    return torch.nn.functional.silu(x)
def _sigmoid(x):
    return torch.sigmoid(x)
def _layernorm(x, axis=-1, eps=1e-5):
    m = x.mean(dim=axis, keepdim=True)
    v = x.var(dim=axis, keepdim=True, unbiased=False)
    return (x - m) / torch.sqrt(v + eps)
def _scatter_add(tgt, idx, src, axis=0):
    return tgt.clone().index_add_(axis, idx, src)
def _segment_sum(src, seg, n):
    out = torch.zeros((n,) + src.shape[1:], dtype=src.dtype)
    return out.index_add_(0, seg, src)
def _pad(x, pw):
    flat = tuple(v for pair in reversed(pw) for v in pair)
    return torch.nn.functional.pad(x, flat)

kernel_name = 'standalone__channel_attn_eca__vision'

def setup_inputs():

    _w = (lambda a: (lambda t: t.to(torch.bfloat16) if t.is_floating_point() else t)(torch.as_tensor(a)))
    H = W = 512
    C = 192
    k = 1
    return {
        "x": _w((lambda *s: torch.randn(*s, dtype=torch.bfloat16) * 0.4)(1, H, W, C) + (lambda *s: torch.randn(*s, dtype=torch.bfloat16) * 0.4)(1, 1, 1, C) * 2.0),
        "w1d": _w((lambda *s: torch.randn(*s, dtype=torch.bfloat16) * 0.4)(k)),
    }

def reference(x, w1d):
    B, H, W, C = x.shape
    k = 1
    pad = k // 2
    g = torch.einsum("bhwc->bc", x) / (H * W)
    gp = _pad(g, ((0, 0), (pad, pad)))
    s = torch.zeros_like(g)
    for i in range(k):
        s = s + gp[:, i:i + C] * w1d[i]
    s = _sigmoid(s)
    return x * s[:, None, None, :]
```

```asm
; @launch grid=(256,1,1) block=(768,1,1) lds=26384
.amdgcn_target "amdgcn-amd-amdhsa--gfx950"
.text
.globl standalone__channel_attn_eca__vision_kernel
.p2align 8
.type standalone__channel_attn_eca__vision_kernel,@function
standalone__channel_attn_eca__vision_kernel:
  s_cmp_ge_u32 s2, 256
  s_cbranch_scc1 L_end
  s_load_dwordx4 s[4:7], s[0:1], 0
  s_load_dwordx4 s[8:11], s[0:1], 16
  s_load_dwordx2 s[12:13], s[0:1], 32
  s_cmp_ge_u32 s2, 16
  s_cbranch_scc1 L_nocpf2
  s_getpc_b64 s[40:41]
L_pc:
  v_lshlrev_b32 v3, 6, v0
  v_cmp_gt_u32 vcc, (L_end-L_pc)/64, v0
  s_and_saveexec_b64 s[44:45], vcc
  s_cbranch_execz L_nocpf
  global_load_dword v19, v3, s[40:41]
L_nocpf:
  s_mov_b64 exec, s[44:45]
L_nocpf2:
  v_lshrrev_b32 v2, 6, v0
  v_lshlrev_b32 v1, 4, v0
  v_readfirstlane_b32 s37, v2
  s_mul_i32 s36, s2, 12288
  s_mov_b32 s38, 0xffff0000
  s_mov_b32 s43, 3145728
  s_getreg_b32 s48, hwreg(HW_REG_XCC_ID, 0, 3)
  s_cmp_lg_u32 s37, 11
  s_cbranch_scc1 L_noclr
  v_mov_b32 v2, 26368
  v_mov_b32 v3, 0
  ds_write_b32 v2, v3
L_noclr:
  s_waitcnt lgkmcnt(0)
  s_mov_b32 s16, s4
  s_and_b32 s17, s5, 0xffff
  s_mov_b32 s18, 100663296
  s_mov_b32 s19, 0x20000
  s_mov_b32 s20, s8
  s_and_b32 s21, s9, 0xffff
  s_mov_b32 s22, 100663296
  s_mov_b32 s23, 0x20000
  s_mov_b32 s24, s12
  s_and_b32 s25, s13, 0xffff
  s_mov_b32 s26, 402653184
  s_mov_b32 s27, 0x20000
  s_cmp_eq_u32 s37, 10
  s_cselect_b32 s39, 5, 0
  s_cmp_eq_u32 s37, 9
  s_cselect_b32 s39, 1, s39
  s_cmp_ge_u32 s2, s39
  s_cbranch_scc1 L_nopst
  s_bitcmp1_b32 s2, 0
  s_cbranch_scc1 L_nopst
  s_mul_i32 s39, s2, 3145728
  s_and_b32 s44, s8, 0x3c00
  s_sub_u32 s44, s39, s44
  s_add_u32 s44, s44, 84951040
  s_cmp_eq_u32 s37, 9
  s_cselect_b32 s44, 1572864, s44
  s_cselect_b64 s[72:73], s[24:25], s[20:21]
  s_cselect_b64 s[74:75], s[26:27], s[22:23]
  s_cselect_b64 s[62:63], s[12:13], s[8:9]
  v_mbcnt_lo_u32_b32 v0, -1, 0
  v_mbcnt_hi_u32_b32 v0, -1, v0
  v_lshl_add_u32 v2, v0, 4, s44
  v_mov_b32 v4, -1
  v_mov_b32 v5, -1
  v_mov_b32 v6, -1
  v_mov_b32 v7, -1
  s_movk_i32 s39, 0x2000
  buffer_store_dwordx4 v[4:7], v2, s[72:75], 0 offen sc1
  buffer_store_dwordx4 v[4:7], v2, s[72:75], s39 offen sc1
L_nopst:
  s_barrier
  s_cmp_lt_u32 s37, 9
  s_cbranch_scc1 L_static
  s_mov_b32 s28, s10
  s_and_b32 s29, s11, 0xffff
  s_mov_b32 s30, 256
  s_mov_b32 s31, 0x20000
  s_cmp_eq_u32 s37, 10
  s_cselect_b32 s39, 5, 0
  s_cmp_eq_u32 s37, 9
  s_cselect_b32 s39, 1, s39
  s_cmp_ge_u32 s2, s39
  s_cbranch_scc1 L_novote
  s_bitcmp1_b32 s2, 0
  s_cbranch_scc1 L_novote
  s_setprio 3
  s_add_u32 s62, s62, s44
  s_addc_u32 s63, s63, 0
  s_mov_b32 s40, -1
  s_mov_b32 s41, -1
  s_cmp_eq_u32 s37, 9
  s_cselect_b32 s32, 6, 4
  s_mov_b32 s33, 0
  s_waitcnt vmcnt(0) lgkmcnt(0)
L_vloop:
  s_and_b32 s35, s33, 1
  s_lshl_b32 s34, s35, 13
  s_lshr_b32 s39, s33, 1
  s_lshl_b32 s39, s39, 7
  s_add_u32 s34, s34, s39
  s_memtime s[60:61]
  s_waitcnt lgkmcnt(0)
  s_load_dword s39, s[62:63], s34
  s_waitcnt lgkmcnt(0)
  s_memtime s[14:15]
  s_waitcnt lgkmcnt(0)
  s_sub_u32 s46, s14, s60
  s_add_u32 s33, s33, 1
  s_min_u32 s47, s40, s46
  s_min_u32 s46, s41, s46
  s_cmp_eq_u32 s35, 0
  s_cselect_b32 s40, s47, s40
  s_cselect_b32 s41, s41, s46
  s_cbranch_scc1 L_vloop
  s_cmp_lt_u32 s33, s32
  s_cbranch_scc1 L_vloop
  s_mul_i32 s46, s40, 3
  s_mul_i32 s47, s41, 2
  s_cmp_le_u32 s46, s47
  s_cbranch_scc1 L_vdone
  s_mul_i32 s46, s41, 3
  s_mul_i32 s47, s40, 2
  s_cmp_le_u32 s46, s47
  s_cbranch_scc1 L_vdone
  s_cmp_lt_u32 s33, 16
  s_cbranch_scc1 L_vloop
L_vdone:
  s_cmp_lt_u32 s41, s40
  s_cselect_b32 s39, 1, 0
  s_lshr_b32 s40, s48, 2
  s_xor_b32 s39, s39, s40
  s_and_b32 s40, s8, 0x1ffc00
  s_add_u32 s40, s40, s44
  s_lshr_b32 s40, s40, 21
  s_cmp_eq_u32 s37, 9
  s_cselect_b32 s40, 0, s40
  s_lshl_b32 s41, s2, 1
  s_add_u32 s41, s41, 32
  s_cmp_eq_u32 s37, 9
  s_cselect_b32 s41, 44, s41
  s_xor_b32 s39, s39, s40
  s_and_b32 s39, s39, 1
  s_lshl_b32 s39, s39, 1
  s_lshl_b32 s40, s48, 2
  s_or_b32 s39, s39, s40
  s_or_b32 s39, s39, 1
  v_mbcnt_lo_u32_b32 v2, -1, 0
  v_mbcnt_hi_u32_b32 v2, -1, v2
  v_lshl_add_u32 v2, v2, 6, s41
  v_mov_b32 v3, s39
  s_mov_b64 exec, 15
  buffer_store_dword v3, v2, s[28:31], 0 offen sc1
  s_mov_b64 exec, -1
  s_setprio 0
L_novote:
  s_cmp_lg_u32 s37, 11
  s_cbranch_scc1 L_static
  s_bitcmp1_b32 s2, 0
  s_cbranch_scc1 L_static
  s_lshr_b32 s92, s2, 1
  s_cmp_lt_u32 s92, 48
  s_cbranch_scc0 L_static
  s_setprio 3
  v_mov_b32 v16, -1
  v_mov_b32 v17, -1
  v_mov_b32 v18, -1
  v_mov_b32 v19, -1
  v_mbcnt_lo_u32_b32 v13, -1, 0
  v_mbcnt_hi_u32_b32 v13, -1, v13
  s_lshl_b32 s39, s92, 14
  v_lshl_add_u32 v14, v13, 4, s39
  s_movk_i32 s40, 0x2000
  buffer_store_dwordx4 v[16:19], v14, s[24:27], 0 offen offset:0 sc1
  buffer_store_dwordx4 v[16:19], v14, s[24:27], 0 offen offset:1024 sc1
  buffer_store_dwordx4 v[16:19], v14, s[24:27], 0 offen offset:2048 sc1
  buffer_store_dwordx4 v[16:19], v14, s[24:27], 0 offen offset:3072 sc1
  buffer_store_dwordx4 v[16:19], v14, s[24:27], s40 offen offset:0 sc1
  buffer_store_dwordx4 v[16:19], v14, s[24:27], s40 offen offset:1024 sc1
  buffer_store_dwordx4 v[16:19], v14, s[24:27], s40 offen offset:2048 sc1
  buffer_store_dwordx4 v[16:19], v14, s[24:27], s40 offen offset:3072 sc1
  v_lshrrev_b32 v15, 2, v13
  v_and_b32 v13, 3, v13
  v_lshlrev_b32 v13, 2, v13
  v_lshl_add_u32 v13, v15, 13, v13
  s_lshl_b32 s39, s92, 7
  s_add_u32 s39, s39, 1048576
  v_add_u32 v13, s39, v13
  buffer_store_dword v16, v13, s[24:27], 0 offen sc1
  s_mov_b32 s39, s92
  s_cmp_ge_u32 s92, 8
  s_cselect_b32 s40, 4, 0
  s_add_u32 s39, s39, s40
  s_cmp_ge_u32 s92, 20
  s_cselect_b32 s40, 4, 0
  s_add_u32 s39, s39, s40
  s_cmp_ge_u32 s92, 32
  s_cselect_b32 s40, 4, 0
  s_add_u32 s39, s39, s40
  s_cmp_ge_u32 s92, 44
  s_cselect_b32 s40, 4, 0
  s_add_u32 s39, s39, s40
  s_lshl_b32 s39, s39, 2
  v_mov_b32 v13, s39
  v_mov_b32 v14, 1
  s_waitcnt vmcnt(0)
  s_mov_b64 exec, 1
  buffer_store_dword v14, v13, s[28:31], 0 offen sc1
  s_mov_b64 exec, -1
  s_setprio 0
L_static:
  s_mov_b32 s42, s36
  buffer_load_dwordx4 v[20:23], v1, s[16:19], s42 offen nt
  s_add_u32 s42, s42, s43
  buffer_load_dwordx4 v[24:27], v1, s[16:19], s42 offen nt
  s_add_u32 s42, s42, s43
  buffer_load_dwordx4 v[28:31], v1, s[16:19], s42 offen nt
  s_add_u32 s42, s42, s43
  buffer_load_dwordx4 v[32:35], v1, s[16:19], s42 offen nt
  s_add_u32 s42, s42, s43
  buffer_load_dwordx4 v[36:39], v1, s[16:19], s42 offen nt
  s_add_u32 s42, s42, s43
  buffer_load_dwordx4 v[40:43], v1, s[16:19], s42 offen nt
  s_add_u32 s42, s42, s43
  buffer_load_dwordx4 v[44:47], v1, s[16:19], s42 offen nt
  s_add_u32 s42, s42, s43
  buffer_load_dwordx4 v[48:51], v1, s[16:19], s42 offen nt
  s_add_u32 s42, s42, s43
  buffer_load_dwordx4 v[52:55], v1, s[16:19], s42 offen nt
  s_add_u32 s42, s42, s43
  buffer_load_dwordx4 v[56:59], v1, s[16:19], s42 offen nt
  s_add_u32 s42, s42, s43
  buffer_load_dwordx4 v[60:63], v1, s[16:19], s42 offen nt
  s_add_u32 s42, s42, s43
  buffer_load_dwordx4 v[64:67], v1, s[16:19], s42 offen nt
  s_add_u32 s42, s42, s43
  buffer_load_dwordx4 v[68:71], v1, s[16:19], s42 offen nt
  s_add_u32 s42, s42, s43
  buffer_load_dwordx4 v[72:75], v1, s[16:19], s42 offen nt
  s_add_u32 s42, s42, s43
  buffer_load_dwordx4 v[76:79], v1, s[16:19], s42 offen nt
  s_add_u32 s42, s42, s43
  buffer_load_dwordx4 v[80:83], v1, s[16:19], s42 offen nt
  s_add_u32 s42, s42, s43
  buffer_load_dwordx4 v[84:87], v1, s[16:19], s42 offen nt
  s_add_u32 s42, s42, s43
  buffer_load_dwordx4 v[88:91], v1, s[16:19], s42 offen nt
  s_add_u32 s42, s42, s43
  buffer_load_dwordx4 v[92:95], v1, s[16:19], s42 offen nt
  s_add_u32 s42, s42, s43
  buffer_load_dwordx4 v[96:99], v1, s[16:19], s42 offen nt
  s_add_u32 s42, s42, s43
  buffer_load_dwordx4 v[100:103], v1, s[16:19], s42 offen nt
  s_add_u32 s42, s42, s43
  buffer_load_dwordx4 v[104:107], v1, s[16:19], s42 offen nt
  s_add_u32 s42, s42, s43
  buffer_load_dwordx4 v[108:111], v1, s[16:19], s42 offen nt
  s_add_u32 s42, s42, s43
  buffer_load_dwordx4 v[112:115], v1, s[16:19], s42 offen nt
  s_add_u32 s42, s42, s43
  buffer_load_dwordx4 v[116:119], v1, s[16:19], s42 offen nt
  s_add_u32 s42, s42, s43
  buffer_load_dwordx4 v[120:123], v1, s[16:19], s42 offen nt
  s_mov_b32 s28, s10
  s_and_b32 s29, s11, 0xffff
  s_mov_b32 s30, 256
  s_mov_b32 s31, 0x20000
  s_mov_b32 s32, s6
  s_and_b32 s33, s7, 0xffff
  s_mov_b32 s34, 2
  s_mov_b32 s35, 0x20000
  v_mov_b32 v4, 0
  v_mov_b32 v5, 0
  v_mov_b32 v6, 0
  v_mov_b32 v7, 0
  v_mov_b32 v8, 0
  v_mov_b32 v9, 0
  v_mov_b32 v10, 0
  v_mov_b32 v11, 0
  s_and_b32 s49, s8, 0x1ffc00
  s_lshr_b32 s41, s49, 10
  s_and_b32 s41, s41, 15
  s_lshr_b32 s39, s37, 2
  s_and_b32 s40, s37, 3
  s_add_u32 s39, s39, s41
  s_sub_u32 s40, s40, s41
  s_add_u32 s44, s39, 6
  s_mul_i32 s46, s44, 86
  s_lshr_b32 s46, s46, 8
  s_mul_i32 s46, s46, 3
  s_sub_u32 s44, s44, s46
  s_lshl_b32 s44, s44, 4
  s_add_u32 s44, s44, s40
  s_add_u32 s44, s44, 48
  s_cmp_ge_u32 s44, 96
  s_cselect_b32 s46, 48, 0
  s_sub_u32 s44, s44, s46
  s_cmp_ge_u32 s44, 48
  s_cselect_b32 s46, 48, 0
  s_sub_u32 s44, s44, s46
  s_sub_u32 s44, s44, s37
  s_lshl_b32 s4, s44, 10
  s_add_u32 s44, s39, 5
  s_mul_i32 s46, s44, 86
  s_lshr_b32 s46, s46, 8
  s_mul_i32 s46, s46, 3
  s_sub_u32 s44, s44, s46
  s_lshl_b32 s44, s44, 4
  s_add_u32 s44, s44, s40
  s_add_u32 s44, s44, 52
  s_cmp_ge_u32 s44, 96
  s_cselect_b32 s46, 48, 0
  s_sub_u32 s44, s44, s46
  s_cmp_ge_u32 s44, 48
  s_cselect_b32 s46, 48, 0
  s_sub_u32 s44, s44, s46
  s_sub_u32 s44, s44, s37
  s_lshl_b32 s5, s44, 10
  s_add_u32 s44, s39, 4
  s_mul_i32 s46, s44, 86
  s_lshr_b32 s46, s46, 8
  s_mul_i32 s46, s46, 3
  s_sub_u32 s44, s44, s46
  s_lshl_b32 s44, s44, 4
  s_add_u32 s44, s44, s40
  s_add_u32 s44, s44, 56
  s_cmp_ge_u32 s44, 96
  s_cselect_b32 s46, 48, 0
  s_sub_u32 s44, s44, s46
  s_cmp_ge_u32 s44, 48
  s_cselect_b32 s46, 48, 0
  s_sub_u32 s44, s44, s46
  s_sub_u32 s44, s44, s37
  s_lshl_b32 s6, s44, 10
  s_add_u32 s44, s39, 3
  s_mul_i32 s46, s44, 86
  s_lshr_b32 s46, s46, 8
  s_mul_i32 s46, s46, 3
  s_sub_u32 s44, s44, s46
  s_lshl_b32 s44, s44, 4
  s_add_u32 s44, s44, s40
  s_add_u32 s44, s44, 60
  s_cmp_ge_u32 s44, 96
  s_cselect_b32 s46, 48, 0
  s_sub_u32 s44, s44, s46
  s_cmp_ge_u32 s44, 48
  s_cselect_b32 s46, 48, 0
  s_sub_u32 s44, s44, s46
  s_sub_u32 s44, s44, s37
  s_lshl_b32 s7, s44, 10
  s_cmp_lg_u32 s37, 0
  s_cbranch_scc1 L_noread
  s_sleep 60
  s_load_dwordx4 s[72:75], s[10:11], 160
  s_waitcnt lgkmcnt(0)
  s_min_u32 s39, s72, s73
  s_min_u32 s39, s39, s74
  s_cmp_lg_u32 s39, 0
  s_cbranch_scc1 L_dgot
  s_sleep 24
  s_load_dwordx4 s[72:75], s[10:11], 224
  s_waitcnt lgkmcnt(0)
  s_min_u32 s39, s72, s73
  s_min_u32 s39, s39, s74
  s_cmp_lg_u32 s39, 0
  s_cbranch_scc1 L_dgot
  s_sleep 24
  s_load_dwordx4 s[72:75], s[10:11], 96
  s_waitcnt lgkmcnt(0)
  s_min_u32 s39, s72, s73
  s_min_u32 s39, s39, s74
  s_cmp_lg_u32 s39, 0
  s_cbranch_scc1 L_dgot
  s_sleep 24
  s_load_dwordx4 s[72:75], s[10:11], 32
  s_waitcnt lgkmcnt(0)
  s_min_u32 s39, s72, s73
  s_min_u32 s39, s39, s74
  s_cmp_lg_u32 s39, 0
  s_cbranch_scc1 L_dgot
  s_mov_b32 s45, 200000
L_dpoll:
  v_mov_b32 v2, 160
  buffer_load_dwordx3 v[12:14], v2, s[28:31], 0 offen sc1
  s_waitcnt vmcnt(0)
  v_readfirstlane_b32 s72, v12
  v_readfirstlane_b32 s73, v13
  v_readfirstlane_b32 s74, v14
  s_min_u32 s39, s72, s73
  s_min_u32 s39, s39, s74
  s_cmp_lg_u32 s39, 0
  s_cbranch_scc1 L_dgot
  s_sleep 2
  s_sub_u32 s45, s45, 1
  s_cbranch_scc0 L_dpoll
L_dgot:
  s_and_b32 s39, s72, s73
  s_or_b32 s40, s72, s73
  s_and_b32 s40, s40, s74
  s_or_b32 s39, s39, s40
  s_and_b32 s39, s39, 2
  s_andn2_b32 s40, s72, 2
  s_or_b32 s39, s39, s40
  s_or_b32 s39, s39, 0x10000
  v_mov_b32 v0, s39
  v_mov_b32 v2, 26368
  s_mov_b64 exec, 1
  ds_write_b32 v2, v0
  s_mov_b64 exec, -1
L_noread:
  v_mov_b32 v0, 26368
  s_mov_b32 s45, 1600000
L_waitt:
  ds_read_b32 v2, v0
  s_waitcnt lgkmcnt(0)
  v_readfirstlane_b32 s46, v2
  s_cmp_ge_u32 s46, 0x10000
  s_cbranch_scc1 L_gott
  s_sleep 4
  s_sub_u32 s45, s45, 1
  s_cbranch_scc0 L_waitt
L_gott:
  s_bfe_u32 s90, s46, 0x30002
  s_bfe_u32 s3, s46, 0x10001
  s_add_u32 s46, s90, s2
  s_and_b32 s39, s46, 3
  s_lshr_b32 s40, s2, 3
  s_lshl_b32 s40, s40, 2
  s_add_u32 s39, s39, s40
  s_mul_i32 s39, s39, 49152
  s_add_u32 s39, s39, 81788928
  s_bfe_u32 s40, s46, 0x10002
  s_xor_b32 s40, s40, s3
  s_add_u32 s41, s39, s49
  s_lshr_b32 s41, s41, 21
  s_xor_b32 s41, s41, s40
  s_bitcmp1_b32 s41, 0
  s_cselect_b32 s44, s6, s4
  s_cselect_b32 s41, s7, s5
  s_add_u32 s64, s39, s44
  s_add_u32 s65, s39, s41
  buffer_load_dwordx4 v[124:127], v1, s[16:19], s64 offen nt
  buffer_load_dwordx4 v[128:131], v1, s[16:19], s65 offen nt
  s_add_u32 s39, s39, 6291456
  s_add_u32 s41, s39, s49
  s_lshr_b32 s41, s41, 21
  s_xor_b32 s41, s41, s40
  s_bitcmp1_b32 s41, 0
  s_cselect_b32 s44, s6, s4
  s_cselect_b32 s41, s7, s5
  s_add_u32 s66, s39, s44
  s_add_u32 s67, s39, s41
  buffer_load_dwordx4 v[132:135], v1, s[16:19], s66 offen nt
  buffer_load_dwordx4 v[136:139], v1, s[16:19], s67 offen nt
  s_add_u32 s39, s39, 6291456
  s_add_u32 s41, s39, s49
  s_lshr_b32 s41, s41, 21
  s_xor_b32 s41, s41, s40
  s_bitcmp1_b32 s41, 0
  s_cselect_b32 s44, s6, s4
  s_cselect_b32 s41, s7, s5
  s_add_u32 s68, s39, s44
  s_add_u32 s69, s39, s41
  buffer_load_dwordx4 v[140:143], v1, s[16:19], s68 offen nt
  buffer_load_dwordx4 v[144:147], v1, s[16:19], s69 offen nt
  s_waitcnt vmcnt(31)
  v_lshlrev_b32 v12, 16, v20
  v_and_b32 v13, s38, v20
  v_lshlrev_b32 v14, 16, v21
  v_and_b32 v15, s38, v21
  v_lshlrev_b32 v16, 16, v22
  v_and_b32 v17, s38, v22
  v_lshlrev_b32 v18, 16, v23
  v_and_b32 v19, s38, v23
  v_pk_add_f32 v[4:5], v[4:5], v[12:13]
  v_pk_add_f32 v[6:7], v[6:7], v[14:15]
  v_pk_add_f32 v[8:9], v[8:9], v[16:17]
  v_pk_add_f32 v[10:11], v[10:11], v[18:19]
  s_waitcnt vmcnt(30)
  v_lshlrev_b32 v12, 16, v24
  v_and_b32 v13, s38, v24
  v_lshlrev_b32 v14, 16, v25
  v_and_b32 v15, s38, v25
  v_lshlrev_b32 v16, 16, v26
  v_and_b32 v17, s38, v26
  v_lshlrev_b32 v18, 16, v27
  v_and_b32 v19, s38, v27
  v_pk_add_f32 v[4:5], v[4:5], v[12:13]
  v_pk_add_f32 v[6:7], v[6:7], v[14:15]
  v_pk_add_f32 v[8:9], v[8:9], v[16:17]
  v_pk_add_f32 v[10:11], v[10:11], v[18:19]
  s_waitcnt vmcnt(29)
  v_lshlrev_b32 v12, 16, v28
  v_and_b32 v13, s38, v28
  v_lshlrev_b32 v14, 16, v29
  v_and_b32 v15, s38, v29
  v_lshlrev_b32 v16, 16, v30
  v_and_b32 v17, s38, v30
  v_lshlrev_b32 v18, 16, v31
  v_and_b32 v19, s38, v31
  v_pk_add_f32 v[4:5], v[4:5], v[12:13]
  v_pk_add_f32 v[6:7], v[6:7], v[14:15]
  v_pk_add_f32 v[8:9], v[8:9], v[16:17]
  v_pk_add_f32 v[10:11], v[10:11], v[18:19]
  s_waitcnt vmcnt(28)
  v_lshlrev_b32 v12, 16, v32
  v_and_b32 v13, s38, v32
  v_lshlrev_b32 v14, 16, v33
  v_and_b32 v15, s38, v33
  v_lshlrev_b32 v16, 16, v34
  v_and_b32 v17, s38, v34
  v_lshlrev_b32 v18, 16, v35
  v_and_b32 v19, s38, v35
  v_pk_add_f32 v[4:5], v[4:5], v[12:13]
  v_pk_add_f32 v[6:7], v[6:7], v[14:15]
  v_pk_add_f32 v[8:9], v[8:9], v[16:17]
  v_pk_add_f32 v[10:11], v[10:11], v[18:19]
  s_waitcnt vmcnt(27)
  v_lshlrev_b32 v12, 16, v36
  v_and_b32 v13, s38, v36
  v_lshlrev_b32 v14, 16, v37
  v_and_b32 v15, s38, v37
  v_lshlrev_b32 v16, 16, v38
  v_and_b32 v17, s38, v38
  v_lshlrev_b32 v18, 16, v39
  v_and_b32 v19, s38, v39
  v_pk_add_f32 v[4:5], v[4:5], v[12:13]
  v_pk_add_f32 v[6:7], v[6:7], v[14:15]
  v_pk_add_f32 v[8:9], v[8:9], v[16:17]
  v_pk_add_f32 v[10:11], v[10:11], v[18:19]
  s_waitcnt vmcnt(26)
  v_lshlrev_b32 v12, 16, v40
  v_and_b32 v13, s38, v40
  v_lshlrev_b32 v14, 16, v41
  v_and_b32 v15, s38, v41
  v_lshlrev_b32 v16, 16, v42
  v_and_b32 v17, s38, v42
  v_lshlrev_b32 v18, 16, v43
  v_and_b32 v19, s38, v43
  v_pk_add_f32 v[4:5], v[4:5], v[12:13]
  v_pk_add_f32 v[6:7], v[6:7], v[14:15]
  v_pk_add_f32 v[8:9], v[8:9], v[16:17]
  v_pk_add_f32 v[10:11], v[10:11], v[18:19]
  s_waitcnt vmcnt(25)
  v_lshlrev_b32 v12, 16, v44
  v_and_b32 v13, s38, v44
  v_lshlrev_b32 v14, 16, v45
  v_and_b32 v15, s38, v45
  v_lshlrev_b32 v16, 16, v46
  v_and_b32 v17, s38, v46
  v_lshlrev_b32 v18, 16, v47
  v_and_b32 v19, s38, v47
  v_pk_add_f32 v[4:5], v[4:5], v[12:13]
  v_pk_add_f32 v[6:7], v[6:7], v[14:15]
  v_pk_add_f32 v[8:9], v[8:9], v[16:17]
  v_pk_add_f32 v[10:11], v[10:11], v[18:19]
  s_waitcnt vmcnt(24)
  v_lshlrev_b32 v12, 16, v48
  v_and_b32 v13, s38, v48
  v_lshlrev_b32 v14, 16, v49
  v_and_b32 v15, s38, v49
  v_lshlrev_b32 v16, 16, v50
  v_and_b32 v17, s38, v50
  v_lshlrev_b32 v18, 16, v51
  v_and_b32 v19, s38, v51
  v_pk_add_f32 v[4:5], v[4:5], v[12:13]
  v_pk_add_f32 v[6:7], v[6:7], v[14:15]
  v_pk_add_f32 v[8:9], v[8:9], v[16:17]
  v_pk_add_f32 v[10:11], v[10:11], v[18:19]
  s_waitcnt vmcnt(23)
  v_lshlrev_b32 v12, 16, v52
  v_and_b32 v13, s38, v52
  v_lshlrev_b32 v14, 16, v53
  v_and_b32 v15, s38, v53
  v_lshlrev_b32 v16, 16, v54
  v_and_b32 v17, s38, v54
  v_lshlrev_b32 v18, 16, v55
  v_and_b32 v19, s38, v55
  v_pk_add_f32 v[4:5], v[4:5], v[12:13]
  v_pk_add_f32 v[6:7], v[6:7], v[14:15]
  v_pk_add_f32 v[8:9], v[8:9], v[16:17]
  v_pk_add_f32 v[10:11], v[10:11], v[18:19]
  s_waitcnt vmcnt(22)
  v_lshlrev_b32 v12, 16, v56
  v_and_b32 v13, s38, v56
  v_lshlrev_b32 v14, 16, v57
  v_and_b32 v15, s38, v57
  v_lshlrev_b32 v16, 16, v58
  v_and_b32 v17, s38, v58
  v_lshlrev_b32 v18, 16, v59
  v_and_b32 v19, s38, v59
  v_pk_add_f32 v[4:5], v[4:5], v[12:13]
  v_pk_add_f32 v[6:7], v[6:7], v[14:15]
  v_pk_add_f32 v[8:9], v[8:9], v[16:17]
  v_pk_add_f32 v[10:11], v[10:11], v[18:19]
  s_waitcnt vmcnt(21)
  v_lshlrev_b32 v12, 16, v60
  v_and_b32 v13, s38, v60
  v_lshlrev_b32 v14, 16, v61
  v_and_b32 v15, s38, v61
  v_lshlrev_b32 v16, 16, v62
  v_and_b32 v17, s38, v62
  v_lshlrev_b32 v18, 16, v63
  v_and_b32 v19, s38, v63
  v_pk_add_f32 v[4:5], v[4:5], v[12:13]
  v_pk_add_f32 v[6:7], v[6:7], v[14:15]
  v_pk_add_f32 v[8:9], v[8:9], v[16:17]
  v_pk_add_f32 v[10:11], v[10:11], v[18:19]
  s_waitcnt vmcnt(20)
  v_lshlrev_b32 v12, 16, v64
  v_and_b32 v13, s38, v64
  v_lshlrev_b32 v14, 16, v65
  v_and_b32 v15, s38, v65
  v_lshlrev_b32 v16, 16, v66
  v_and_b32 v17, s38, v66
  v_lshlrev_b32 v18, 16, v67
  v_and_b32 v19, s38, v67
  v_pk_add_f32 v[4:5], v[4:5], v[12:13]
  v_pk_add_f32 v[6:7], v[6:7], v[14:15]
  v_pk_add_f32 v[8:9], v[8:9], v[16:17]
  v_pk_add_f32 v[10:11], v[10:11], v[18:19]
  s_waitcnt vmcnt(19)
  v_lshlrev_b32 v12, 16, v68
  v_and_b32 v13, s38, v68
  v_lshlrev_b32 v14, 16, v69
  v_and_b32 v15, s38, v69
  v_lshlrev_b32 v16, 16, v70
  v_and_b32 v17, s38, v70
  v_lshlrev_b32 v18, 16, v71
  v_and_b32 v19, s38, v71
  v_pk_add_f32 v[4:5], v[4:5], v[12:13]
  v_pk_add_f32 v[6:7], v[6:7], v[14:15]
  v_pk_add_f32 v[8:9], v[8:9], v[16:17]
  v_pk_add_f32 v[10:11], v[10:11], v[18:19]
  s_waitcnt vmcnt(18)
  v_lshlrev_b32 v12, 16, v72
  v_and_b32 v13, s38, v72
  v_lshlrev_b32 v14, 16, v73
  v_and_b32 v15, s38, v73
  v_lshlrev_b32 v16, 16, v74
  v_and_b32 v17, s38, v74
  v_lshlrev_b32 v18, 16, v75
  v_and_b32 v19, s38, v75
  v_pk_add_f32 v[4:5], v[4:5], v[12:13]
  v_pk_add_f32 v[6:7], v[6:7], v[14:15]
  v_pk_add_f32 v[8:9], v[8:9], v[16:17]
  v_pk_add_f32 v[10:11], v[10:11], v[18:19]
  s_waitcnt vmcnt(17)
  v_lshlrev_b32 v12, 16, v76
  v_and_b32 v13, s38, v76
  v_lshlrev_b32 v14, 16, v77
  v_and_b32 v15, s38, v77
  v_lshlrev_b32 v16, 16, v78
  v_and_b32 v17, s38, v78
  v_lshlrev_b32 v18, 16, v79
  v_and_b32 v19, s38, v79
  v_pk_add_f32 v[4:5], v[4:5], v[12:13]
  v_pk_add_f32 v[6:7], v[6:7], v[14:15]
  v_pk_add_f32 v[8:9], v[8:9], v[16:17]
  v_pk_add_f32 v[10:11], v[10:11], v[18:19]
  s_waitcnt vmcnt(16)
  v_lshlrev_b32 v12, 16, v80
  v_and_b32 v13, s38, v80
  v_lshlrev_b32 v14, 16, v81
  v_and_b32 v15, s38, v81
  v_lshlrev_b32 v16, 16, v82
  v_and_b32 v17, s38, v82
  v_lshlrev_b32 v18, 16, v83
  v_and_b32 v19, s38, v83
  v_pk_add_f32 v[4:5], v[4:5], v[12:13]
  v_pk_add_f32 v[6:7], v[6:7], v[14:15]
  v_pk_add_f32 v[8:9], v[8:9], v[16:17]
  v_pk_add_f32 v[10:11], v[10:11], v[18:19]
  s_cmp_eq_u32 s37, 11
  s_cbranch_scc0 L_midw
  v_mbcnt_lo_u32_b32 v3, -1, 0
  v_mbcnt_hi_u32_b32 v3, -1, v3
  v_lshlrev_b32 v3, 2, v3
  buffer_load_dword v3, v3, s[28:31], 0 offen sc1
  s_branch L_nomid
L_midw:
  s_cmp_eq_u32 s37, 1
  s_cbranch_scc0 L_nomid
  v_mov_b32 v3, 0
  buffer_load_ushort v3, v3, s[32:35], 0 offen
L_nomid:
  s_waitcnt vmcnt(15)
  v_lshlrev_b32 v12, 16, v84
  v_and_b32 v13, s38, v84
  v_lshlrev_b32 v14, 16, v85
  v_and_b32 v15, s38, v85
  v_lshlrev_b32 v16, 16, v86
  v_and_b32 v17, s38, v86
  v_lshlrev_b32 v18, 16, v87
  v_and_b32 v19, s38, v87
  v_pk_add_f32 v[4:5], v[4:5], v[12:13]
  v_pk_add_f32 v[6:7], v[6:7], v[14:15]
  v_pk_add_f32 v[8:9], v[8:9], v[16:17]
  v_pk_add_f32 v[10:11], v[10:11], v[18:19]
  s_waitcnt vmcnt(14)
  v_lshlrev_b32 v12, 16, v88
  v_and_b32 v13, s38, v88
  v_lshlrev_b32 v14, 16, v89
  v_and_b32 v15, s38, v89
  v_lshlrev_b32 v16, 16, v90
  v_and_b32 v17, s38, v90
  v_lshlrev_b32 v18, 16, v91
  v_and_b32 v19, s38, v91
  v_pk_add_f32 v[4:5], v[4:5], v[12:13]
  v_pk_add_f32 v[6:7], v[6:7], v[14:15]
  v_pk_add_f32 v[8:9], v[8:9], v[16:17]
  v_pk_add_f32 v[10:11], v[10:11], v[18:19]
  s_waitcnt vmcnt(13)
  v_lshlrev_b32 v12, 16, v92
  v_and_b32 v13, s38, v92
  v_lshlrev_b32 v14, 16, v93
  v_and_b32 v15, s38, v93
  v_lshlrev_b32 v16, 16, v94
  v_and_b32 v17, s38, v94
  v_lshlrev_b32 v18, 16, v95
  v_and_b32 v19, s38, v95
  v_pk_add_f32 v[4:5], v[4:5], v[12:13]
  v_pk_add_f32 v[6:7], v[6:7], v[14:15]
  v_pk_add_f32 v[8:9], v[8:9], v[16:17]
  v_pk_add_f32 v[10:11], v[10:11], v[18:19]
  s_waitcnt vmcnt(12)
  v_lshlrev_b32 v12, 16, v96
  v_and_b32 v13, s38, v96
  v_lshlrev_b32 v14, 16, v97
  v_and_b32 v15, s38, v97
  v_lshlrev_b32 v16, 16, v98
  v_and_b32 v17, s38, v98
  v_lshlrev_b32 v18, 16, v99
  v_and_b32 v19, s38, v99
  v_pk_add_f32 v[4:5], v[4:5], v[12:13]
  v_pk_add_f32 v[6:7], v[6:7], v[14:15]
  v_pk_add_f32 v[8:9], v[8:9], v[16:17]
  v_pk_add_f32 v[10:11], v[10:11], v[18:19]
  s_waitcnt vmcnt(11)
  v_lshlrev_b32 v12, 16, v100
  v_and_b32 v13, s38, v100
  v_lshlrev_b32 v14, 16, v101
  v_and_b32 v15, s38, v101
  v_lshlrev_b32 v16, 16, v102
  v_and_b32 v17, s38, v102
  v_lshlrev_b32 v18, 16, v103
  v_and_b32 v19, s38, v103
  v_pk_add_f32 v[4:5], v[4:5], v[12:13]
  v_pk_add_f32 v[6:7], v[6:7], v[14:15]
  v_pk_add_f32 v[8:9], v[8:9], v[16:17]
  v_pk_add_f32 v[10:11], v[10:11], v[18:19]
  s_waitcnt vmcnt(10)
  v_lshlrev_b32 v12, 16, v104
  v_and_b32 v13, s38, v104
  v_lshlrev_b32 v14, 16, v105
  v_and_b32 v15, s38, v105
  v_lshlrev_b32 v16, 16, v106
  v_and_b32 v17, s38, v106
  v_lshlrev_b32 v18, 16, v107
  v_and_b32 v19, s38, v107
  v_pk_add_f32 v[4:5], v[4:5], v[12:13]
  v_pk_add_f32 v[6:7], v[6:7], v[14:15]
  v_pk_add_f32 v[8:9], v[8:9], v[16:17]
  v_pk_add_f32 v[10:11], v[10:11], v[18:19]
  s_waitcnt vmcnt(9)
  v_lshlrev_b32 v12, 16, v108
  v_and_b32 v13, s38, v108
  v_lshlrev_b32 v14, 16, v109
  v_and_b32 v15, s38, v109
  v_lshlrev_b32 v16, 16, v110
  v_and_b32 v17, s38, v110
  v_lshlrev_b32 v18, 16, v111
  v_and_b32 v19, s38, v111
  v_pk_add_f32 v[4:5], v[4:5], v[12:13]
  v_pk_add_f32 v[6:7], v[6:7], v[14:15]
  v_pk_add_f32 v[8:9], v[8:9], v[16:17]
  v_pk_add_f32 v[10:11], v[10:11], v[18:19]
  s_waitcnt vmcnt(8)
  v_lshlrev_b32 v12, 16, v112
  v_and_b32 v13, s38, v112
  v_lshlrev_b32 v14, 16, v113
  v_and_b32 v15, s38, v113
  v_lshlrev_b32 v16, 16, v114
  v_and_b32 v17, s38, v114
  v_lshlrev_b32 v18, 16, v115
  v_and_b32 v19, s38, v115
  v_pk_add_f32 v[4:5], v[4:5], v[12:13]
  v_pk_add_f32 v[6:7], v[6:7], v[14:15]
  v_pk_add_f32 v[8:9], v[8:9], v[16:17]
  v_pk_add_f32 v[10:11], v[10:11], v[18:19]
  s_waitcnt vmcnt(7)
  v_lshlrev_b32 v12, 16, v116
  v_and_b32 v13, s38, v116
  v_lshlrev_b32 v14, 16, v117
  v_and_b32 v15, s38, v117
  v_lshlrev_b32 v16, 16, v118
  v_and_b32 v17, s38, v118
  v_lshlrev_b32 v18, 16, v119
  v_and_b32 v19, s38, v119
  v_pk_add_f32 v[4:5], v[4:5], v[12:13]
  v_pk_add_f32 v[6:7], v[6:7], v[14:15]
  v_pk_add_f32 v[8:9], v[8:9], v[16:17]
  v_pk_add_f32 v[10:11], v[10:11], v[18:19]
  s_waitcnt vmcnt(6)
  v_lshlrev_b32 v12, 16, v120
  v_and_b32 v13, s38, v120
  v_lshlrev_b32 v14, 16, v121
  v_and_b32 v15, s38, v121
  v_lshlrev_b32 v16, 16, v122
  v_and_b32 v17, s38, v122
  v_lshlrev_b32 v18, 16, v123
  v_and_b32 v19, s38, v123
  v_pk_add_f32 v[4:5], v[4:5], v[12:13]
  v_pk_add_f32 v[6:7], v[6:7], v[14:15]
  v_pk_add_f32 v[8:9], v[8:9], v[16:17]
  v_pk_add_f32 v[10:11], v[10:11], v[18:19]
  s_waitcnt vmcnt(5)
  v_lshlrev_b32 v12, 16, v124
  v_and_b32 v13, s38, v124
  v_lshlrev_b32 v14, 16, v125
  v_and_b32 v15, s38, v125
  v_lshlrev_b32 v16, 16, v126
  v_and_b32 v17, s38, v126
  v_lshlrev_b32 v18, 16, v127
  v_and_b32 v19, s38, v127
  v_pk_add_f32 v[4:5], v[4:5], v[12:13]
  v_pk_add_f32 v[6:7], v[6:7], v[14:15]
  v_pk_add_f32 v[8:9], v[8:9], v[16:17]
  v_pk_add_f32 v[10:11], v[10:11], v[18:19]
  s_waitcnt vmcnt(4)
  v_lshlrev_b32 v12, 16, v128
  v_and_b32 v13, s38, v128
  v_lshlrev_b32 v14, 16, v129
  v_and_b32 v15, s38, v129
  v_lshlrev_b32 v16, 16, v130
  v_and_b32 v17, s38, v130
  v_lshlrev_b32 v18, 16, v131
  v_and_b32 v19, s38, v131
  v_pk_add_f32 v[4:5], v[4:5], v[12:13]
  v_pk_add_f32 v[6:7], v[6:7], v[14:15]
  v_pk_add_f32 v[8:9], v[8:9], v[16:17]
  v_pk_add_f32 v[10:11], v[10:11], v[18:19]
  s_waitcnt vmcnt(3)
  v_lshlrev_b32 v12, 16, v132
  v_and_b32 v13, s38, v132
  v_lshlrev_b32 v14, 16, v133
  v_and_b32 v15, s38, v133
  v_lshlrev_b32 v16, 16, v134
  v_and_b32 v17, s38, v134
  v_lshlrev_b32 v18, 16, v135
  v_and_b32 v19, s38, v135
  v_pk_add_f32 v[4:5], v[4:5], v[12:13]
  v_pk_add_f32 v[6:7], v[6:7], v[14:15]
  v_pk_add_f32 v[8:9], v[8:9], v[16:17]
  v_pk_add_f32 v[10:11], v[10:11], v[18:19]
  s_waitcnt vmcnt(2)
  v_lshlrev_b32 v12, 16, v136
  v_and_b32 v13, s38, v136
  v_lshlrev_b32 v14, 16, v137
  v_and_b32 v15, s38, v137
  v_lshlrev_b32 v16, 16, v138
  v_and_b32 v17, s38, v138
  v_lshlrev_b32 v18, 16, v139
  v_and_b32 v19, s38, v139
  v_pk_add_f32 v[4:5], v[4:5], v[12:13]
  v_pk_add_f32 v[6:7], v[6:7], v[14:15]
  v_pk_add_f32 v[8:9], v[8:9], v[16:17]
  v_pk_add_f32 v[10:11], v[10:11], v[18:19]
  s_waitcnt vmcnt(1)
  v_lshlrev_b32 v12, 16, v140
  v_and_b32 v13, s38, v140
  v_lshlrev_b32 v14, 16, v141
  v_and_b32 v15, s38, v141
  v_lshlrev_b32 v16, 16, v142
  v_and_b32 v17, s38, v142
  v_lshlrev_b32 v18, 16, v143
  v_and_b32 v19, s38, v143
  v_pk_add_f32 v[4:5], v[4:5], v[12:13]
  v_pk_add_f32 v[6:7], v[6:7], v[14:15]
  v_pk_add_f32 v[8:9], v[8:9], v[16:17]
  v_pk_add_f32 v[10:11], v[10:11], v[18:19]
  v_lshrrev_b32 v2, 4, v1
  v_mul_u32_u24 v2, 43691, v2
  v_lshrrev_b32 v2, 20, v2
  v_lshl_add_u32 v2, v2, 4, v1
  s_waitcnt vmcnt(0)
  v_lshlrev_b32 v12, 16, v144
  v_and_b32 v13, s38, v144
  v_lshlrev_b32 v14, 16, v145
  v_and_b32 v15, s38, v145
  v_lshlrev_b32 v16, 16, v146
  v_and_b32 v17, s38, v146
  v_lshlrev_b32 v18, 16, v147
  v_and_b32 v19, s38, v147
  v_pk_add_f32 v[4:5], v[4:5], v[12:13]
  v_pk_add_f32 v[6:7], v[6:7], v[14:15]
  v_pk_add_f32 v[8:9], v[8:9], v[16:17]
  v_pk_add_f32 v[10:11], v[10:11], v[18:19]
  ds_write_b128 v2, v[4:7]
  ds_write_b128 v2, v[8:11] offset:12800
  v_readfirstlane_b32 s47, v3
  v_lshrrev_b32 v2, 8, v1
  v_bfe_u32 v0, v1, 4, 4
  v_mul_u32_u24 v0, 400, v0
  v_cmp_le_u32 vcc, 24, v2
  v_lshl_add_u32 v0, v2, 4, v0
  v_mov_b32 v12, 12416
  v_cndmask_b32 v12, 0, v12, vcc
  v_add_u32 v0, v0, v12
  s_cmp_lg_u32 s37, 11
  s_cbranch_scc1 L_cntok
  s_mov_b32 s45, 200000
L_cntchk:
  v_cmp_ne_u32 vcc, 0, v3
  s_mov_b32 s40, 0xf0fff8ff
  s_mov_b32 s41, 0xf0fff0ff
  s_and_b64 vcc, vcc, s[40:41]
  s_cmp_eq_u64 vcc, s[40:41]
  s_cbranch_scc1 L_cntok1
  s_sleep 8
  v_mbcnt_lo_u32_b32 v3, -1, 0
  v_mbcnt_hi_u32_b32 v3, -1, v3
  v_lshlrev_b32 v3, 2, v3
  buffer_load_dword v3, v3, s[28:31], 0 offen sc1
  s_waitcnt vmcnt(0)
  s_sub_u32 s45, s45, 1
  s_cbranch_scc0 L_cntchk
  s_branch L_cntok2
L_cntok1:
  v_readlane_b32 s39, v3, 11
  v_mov_b32 v12, 26372
  s_nop 0
  v_mov_b32 v13, s39
  ds_write_b32 v12, v13
L_cntok2:
L_cntok:
  s_waitcnt lgkmcnt(0)
  s_barrier
  v_mov_b32 v12, 26372
  ds_read_b32 v12, v12
  ds_read_b128 v[4:7], v0
  ds_read_b128 v[8:11], v0 offset:6400
  s_waitcnt lgkmcnt(2)
  v_readfirstlane_b32 s91, v12
  s_bfe_u32 s91, s91, 0x10001
  v_lshl_add_u32 v3, v2, 1, s90
  v_bfe_u32 v3, v3, 2, 1
  v_xor_b32 v3, s91, v3
  v_lshlrev_b32 v3, 13, v3
  v_lshl_add_u32 v3, v2, 14, v3
  s_lshl_b32 s39, s2, 4
  v_add_u32 v3, s39, v3
  s_waitcnt lgkmcnt(0)
  v_pk_add_f32 v[4:5], v[4:5], v[8:9]
  v_pk_add_f32 v[6:7], v[6:7], v[10:11]
  s_nop 1
  v_add_f32_dpp v4, v4, v4 row_shr:1 row_mask:0xf bank_mask:0xf bound_ctrl:0
  v_add_f32_dpp v5, v5, v5 row_shr:1 row_mask:0xf bank_mask:0xf bound_ctrl:0
  v_add_f32_dpp v6, v6, v6 row_shr:1 row_mask:0xf bank_mask:0xf bound_ctrl:0
  v_add_f32_dpp v7, v7, v7 row_shr:1 row_mask:0xf bank_mask:0xf bound_ctrl:0
  v_add_f32_dpp v4, v4, v4 row_shr:2 row_mask:0xf bank_mask:0xf bound_ctrl:0
  v_add_f32_dpp v5, v5, v5 row_shr:2 row_mask:0xf bank_mask:0xf bound_ctrl:0
  v_add_f32_dpp v6, v6, v6 row_shr:2 row_mask:0xf bank_mask:0xf bound_ctrl:0
  v_add_f32_dpp v7, v7, v7 row_shr:2 row_mask:0xf bank_mask:0xf bound_ctrl:0
  v_add_f32_dpp v4, v4, v4 row_shr:4 row_mask:0xf bank_mask:0xf bound_ctrl:0
  v_add_f32_dpp v5, v5, v5 row_shr:4 row_mask:0xf bank_mask:0xf bound_ctrl:0
  v_add_f32_dpp v6, v6, v6 row_shr:4 row_mask:0xf bank_mask:0xf bound_ctrl:0
  v_add_f32_dpp v7, v7, v7 row_shr:4 row_mask:0xf bank_mask:0xf bound_ctrl:0
  v_add_f32_dpp v4, v4, v4 row_shr:8 row_mask:0xf bank_mask:0xf bound_ctrl:0
  v_add_f32_dpp v5, v5, v5 row_shr:8 row_mask:0xf bank_mask:0xf bound_ctrl:0
  v_add_f32_dpp v6, v6, v6 row_shr:8 row_mask:0xf bank_mask:0xf bound_ctrl:0
  v_add_f32_dpp v7, v7, v7 row_shr:8 row_mask:0xf bank_mask:0xf bound_ctrl:0
  s_mov_b32 exec_lo, 0x80008000
  s_mov_b32 exec_hi, 0x80008000
  buffer_store_dwordx4 v[4:7], v3, s[24:27], 0 offen sc1
  s_mov_b64 exec, -1
  s_cmp_eq_u32 s37, 0
  s_cbranch_scc1 L_poll_s
  s_cmp_eq_u32 s37, 1
  s_cbranch_scc0 L_wait_s
  s_bitcmp1_b32 s2, 0
  s_cbranch_scc1 L_wait_s
  s_lshr_b32 s92, s2, 1
  s_cmp_lt_u32 s92, 48
  s_cbranch_scc0 L_wait_s
  v_mbcnt_lo_u32_b32 v0, -1, 0
  v_mbcnt_hi_u32_b32 v0, -1, v0
  s_add_u32 s39, s2, s90
  s_bfe_u32 s39, s39, 0x10002
  s_xor_b32 s39, s39, s91
  s_lshl_b32 s39, s39, 13
  s_lshl_b32 s40, s92, 14
  s_add_u32 s39, s39, s40
  v_lshl_add_u32 v0, v0, 4, s39
  s_mov_b32 s45, 200000
L_poll_a:
  buffer_load_dwordx4 v[4:7], v0, s[24:27], 0 offen offset:0 sc1
  buffer_load_dwordx4 v[8:11], v0, s[24:27], 0 offen offset:1024 sc1
  buffer_load_dwordx4 v[12:15], v0, s[24:27], 0 offen offset:2048 sc1
  buffer_load_dwordx4 v[16:19], v0, s[24:27], 0 offen offset:3072 sc1
  s_waitcnt vmcnt(3)
  v_max3_u32 v2, v4, v5, v6
  s_waitcnt vmcnt(2)
  v_max3_u32 v2, v2, v7, v8
  v_max3_u32 v2, v2, v9, v10
  s_waitcnt vmcnt(1)
  v_max3_u32 v2, v2, v11, v12
  v_max3_u32 v2, v2, v13, v14
  s_waitcnt vmcnt(0)
  v_max3_u32 v2, v2, v15, v16
  v_max3_u32 v2, v2, v17, v18
  v_max_u32 v2, v2, v19
  v_cmp_eq_u32 vcc, -1, v2
  s_and_b64 exec, exec, vcc
  s_cbranch_execz L_poll_a_done
  s_sub_u32 s45, s45, 1
  s_cbranch_scc0 L_poll_a
L_poll_a_done:
  s_mov_b64 exec, -1
  v_pk_add_f32 v[4:5], v[4:5], v[8:9]
  v_pk_add_f32 v[6:7], v[6:7], v[10:11]
  v_pk_add_f32 v[12:13], v[12:13], v[16:17]
  v_pk_add_f32 v[14:15], v[14:15], v[18:19]
  s_mov_b32 s40, 0xaaaaaaaa
  s_mov_b32 s41, 0xaaaaaaaa
  v_pk_add_f32 v[4:5], v[4:5], v[12:13]
  v_pk_add_f32 v[6:7], v[6:7], v[14:15]
  s_mov_b32 s44, 0xcccccccc
  s_mov_b32 s45, 0xcccccccc
  v_cndmask_b32 v8, v4, v5, s[40:41]
  v_cndmask_b32 v9, v5, v4, s[40:41]
  v_cndmask_b32 v10, v6, v7, s[40:41]
  v_cndmask_b32 v11, v7, v6, s[40:41]
  s_lshl_b32 s47, s47, 16
  v_add_f32_dpp v8, v9, v8 quad_perm:[1,0,3,2] row_mask:0xf bank_mask:0xf
  v_add_f32_dpp v10, v11, v10 quad_perm:[1,0,3,2] row_mask:0xf bank_mask:0xf
  s_nop 0
  v_cndmask_b32 v4, v8, v10, s[44:45]
  v_cndmask_b32 v5, v10, v8, s[44:45]
  v_mbcnt_lo_u32_b32 v3, -1, 0
  v_mbcnt_hi_u32_b32 v3, -1, v3
  v_lshrrev_b32 v2, 2, v3
  v_and_b32 v3, 3, v3
  v_lshlrev_b32 v3, 2, v3
  v_lshl_add_u32 v3, v2, 14, v3
  v_add_u32 v2, s90, v2
  v_bfe_u32 v2, v2, 2, 1
  v_xor_b32 v2, s91, v2
  v_lshlrev_b32 v2, 13, v2
  s_lshl_b32 s39, s92, 7
  s_add_u32 s39, s39, 1048576
  v_add3_u32 v3, v3, v2, s39
  v_add_f32_dpp v4, v5, v4 quad_perm:[2,3,0,1] row_mask:0xf bank_mask:0xf
  s_nop 1
  v_add_f32_dpp v4, v4, v4 row_ror:4 row_mask:0xf bank_mask:0xf
  s_nop 1
  v_add_f32_dpp v4, v4, v4 row_ror:8 row_mask:0xf bank_mask:0xf
  s_nop 0
  v_mov_b32 v5, v4
  s_nop 1
  v_permlane16_swap_b32 v5, v4
  s_nop 0
  v_add_f32 v4, v4, v5
  s_nop 0
  v_mov_b32 v5, v4
  s_nop 1
  v_permlane32_swap_b32 v5, v4
  s_mov_b32 s39, 0x36800000
  v_add_f32 v4, v4, v5
  v_cvt_pk_bf16_f32 v4, v4, v4
  v_and_b32 v4, s38, v4
  v_mul_f32 v4, s39, v4
  v_cvt_pk_bf16_f32 v4, v4, v4
  v_and_b32 v4, s38, v4
  v_mul_f32 v4, s47, v4
  v_cvt_pk_bf16_f32 v4, v4, v4
  s_mov_b32 s39, 0xbfb8aa3b
  v_and_b32 v4, s38, v4
  v_mul_f32 v4, s39, v4
  v_exp_f32 v4, v4
  s_nop 0
  v_add_f32 v4, 1.0, v4
  v_rcp_f32 v4, v4
  s_nop 0
  v_cvt_pk_bf16_f32 v4, v4, v4
  v_and_b32 v4, s38, v4
  s_mov_b32 exec_hi, 0
  buffer_store_dword v4, v3, s[24:27], 0 offen sc1
  s_mov_b64 exec, -1
  s_branch L_wait_s
L_poll_s:
  v_mbcnt_lo_u32_b32 v2, -1, 0
  v_mbcnt_hi_u32_b32 v2, -1, v2
  s_and_b32 s40, s2, 7
  s_add_u32 s39, s40, s90
  s_bfe_u32 s39, s39, 0x10002
  s_xor_b32 s39, s39, s91
  s_lshl_b32 s39, s39, 13
  s_lshl_b32 s40, s40, 14
  s_add_u32 s39, s39, s40
  s_add_u32 s39, s39, 1048576
  v_lshl_add_u32 v0, v2, 7, s39
  v_lshlrev_b32 v3, 4, v2
  s_mov_b32 exec_hi, 0xffff
  s_mov_b32 s45, 200000
L_poll_s2:
  buffer_load_dwordx4 v[4:7], v0, s[24:27], 0 offen sc1
  s_waitcnt vmcnt(0)
  v_max3_u32 v2, v4, v5, v6
  v_max_u32 v2, v2, v7
  v_cmp_eq_u32 vcc, -1, v2
  s_and_b64 exec, exec, vcc
  s_cbranch_execz L_poll_s_done
  s_sub_u32 s45, s45, 1
  s_cbranch_scc0 L_poll_s2
L_poll_s_done:
  s_mov_b32 exec_lo, -1
  s_mov_b32 exec_hi, 0xffff
  ds_write_b128 v3, v[4:7] offset:25600
  s_mov_b64 exec, -1
  s_waitcnt lgkmcnt(0)
L_wait_s:
  v_lshrrev_b32 v2, 4, v1
  v_mul_u32_u24 v3, 43691, v2
  v_lshrrev_b32 v3, 20, v3
  v_mul_u32_u24 v3, 24, v3
  v_sub_u32 v2, v2, v3
  v_lshlrev_b32 v2, 4, v2
  s_barrier
  ds_read_b128 v[4:7], v2 offset:25600
  ds_read_b128 v[8:11], v2 offset:25984
  s_mov_b32 s42, s36
  s_waitcnt lgkmcnt(0)
  v_lshlrev_b32 v12, 16, v20
  v_and_b32 v13, s38, v20
  v_lshlrev_b32 v14, 16, v21
  v_and_b32 v15, s38, v21
  v_lshlrev_b32 v16, 16, v22
  v_and_b32 v17, s38, v22
  v_lshlrev_b32 v18, 16, v23
  v_and_b32 v19, s38, v23
  v_pk_mul_f32 v[12:13], v[12:13], v[4:5]
  v_pk_mul_f32 v[14:15], v[14:15], v[6:7]
  v_pk_mul_f32 v[16:17], v[16:17], v[8:9]
  v_pk_mul_f32 v[18:19], v[18:19], v[10:11]
  v_cvt_pk_bf16_f32 v20, v12, v13
  v_cvt_pk_bf16_f32 v21, v14, v15
  v_cvt_pk_bf16_f32 v22, v16, v17
  v_cvt_pk_bf16_f32 v23, v18, v19
  buffer_store_dwordx4 v[20:23], v1, s[20:23], s42 offen sc1
  v_lshlrev_b32 v12, 16, v24
  v_and_b32 v13, s38, v24
  v_lshlrev_b32 v14, 16, v25
  v_and_b32 v15, s38, v25
  v_lshlrev_b32 v16, 16, v26
  v_and_b32 v17, s38, v26
  v_lshlrev_b32 v18, 16, v27
  v_and_b32 v19, s38, v27
  v_pk_mul_f32 v[12:13], v[12:13], v[4:5]
  v_pk_mul_f32 v[14:15], v[14:15], v[6:7]
  v_pk_mul_f32 v[16:17], v[16:17], v[8:9]
  v_pk_mul_f32 v[18:19], v[18:19], v[10:11]
  v_cvt_pk_bf16_f32 v24, v12, v13
  v_cvt_pk_bf16_f32 v25, v14, v15
  v_cvt_pk_bf16_f32 v26, v16, v17
  v_cvt_pk_bf16_f32 v27, v18, v19
  s_add_u32 s42, s42, s43
  buffer_store_dwordx4 v[24:27], v1, s[20:23], s42 offen sc1
  v_lshlrev_b32 v12, 16, v124
  v_and_b32 v13, s38, v124
  v_lshlrev_b32 v14, 16, v125
  v_and_b32 v15, s38, v125
  v_lshlrev_b32 v16, 16, v126
  v_and_b32 v17, s38, v126
  v_lshlrev_b32 v18, 16, v127
  v_and_b32 v19, s38, v127
  v_pk_mul_f32 v[12:13], v[12:13], v[4:5]
  v_pk_mul_f32 v[14:15], v[14:15], v[6:7]
  v_pk_mul_f32 v[16:17], v[16:17], v[8:9]
  v_pk_mul_f32 v[18:19], v[18:19], v[10:11]
  v_cvt_pk_bf16_f32 v124, v12, v13
  v_cvt_pk_bf16_f32 v125, v14, v15
  v_cvt_pk_bf16_f32 v126, v16, v17
  v_cvt_pk_bf16_f32 v127, v18, v19
  buffer_store_dwordx4 v[124:127], v1, s[20:23], s64 offen sc1
  v_lshlrev_b32 v12, 16, v28
  v_and_b32 v13, s38, v28
  v_lshlrev_b32 v14, 16, v29
  v_and_b32 v15, s38, v29
  v_lshlrev_b32 v16, 16, v30
  v_and_b32 v17, s38, v30
  v_lshlrev_b32 v18, 16, v31
  v_and_b32 v19, s38, v31
  v_pk_mul_f32 v[12:13], v[12:13], v[4:5]
  v_pk_mul_f32 v[14:15], v[14:15], v[6:7]
  v_pk_mul_f32 v[16:17], v[16:17], v[8:9]
  v_pk_mul_f32 v[18:19], v[18:19], v[10:11]
  v_cvt_pk_bf16_f32 v28, v12, v13
  v_cvt_pk_bf16_f32 v29, v14, v15
  v_cvt_pk_bf16_f32 v30, v16, v17
  v_cvt_pk_bf16_f32 v31, v18, v19
  s_add_u32 s42, s42, s43
  buffer_store_dwordx4 v[28:31], v1, s[20:23], s42 offen sc1
  v_lshlrev_b32 v12, 16, v32
  v_and_b32 v13, s38, v32
  v_lshlrev_b32 v14, 16, v33
  v_and_b32 v15, s38, v33
  v_lshlrev_b32 v16, 16, v34
  v_and_b32 v17, s38, v34
  v_lshlrev_b32 v18, 16, v35
  v_and_b32 v19, s38, v35
  v_pk_mul_f32 v[12:13], v[12:13], v[4:5]
  v_pk_mul_f32 v[14:15], v[14:15], v[6:7]
  v_pk_mul_f32 v[16:17], v[16:17], v[8:9]
  v_pk_mul_f32 v[18:19], v[18:19], v[10:11]
  v_cvt_pk_bf16_f32 v32, v12, v13
  v_cvt_pk_bf16_f32 v33, v14, v15
  v_cvt_pk_bf16_f32 v34, v16, v17
  v_cvt_pk_bf16_f32 v35, v18, v19
  s_add_u32 s42, s42, s43
  buffer_store_dwordx4 v[32:35], v1, s[20:23], s42 offen sc1
  v_lshlrev_b32 v12, 16, v36
  v_and_b32 v13, s38, v36
  v_lshlrev_b32 v14, 16, v37
  v_and_b32 v15, s38, v37
  v_lshlrev_b32 v16, 16, v38
  v_and_b32 v17, s38, v38
  v_lshlrev_b32 v18, 16, v39
  v_and_b32 v19, s38, v39
  v_pk_mul_f32 v[12:13], v[12:13], v[4:5]
  v_pk_mul_f32 v[14:15], v[14:15], v[6:7]
  v_pk_mul_f32 v[16:17], v[16:17], v[8:9]
  v_pk_mul_f32 v[18:19], v[18:19], v[10:11]
  v_cvt_pk_bf16_f32 v36, v12, v13
  v_cvt_pk_bf16_f32 v37, v14, v15
  v_cvt_pk_bf16_f32 v38, v16, v17
  v_cvt_pk_bf16_f32 v39, v18, v19
  s_add_u32 s42, s42, s43
  buffer_store_dwordx4 v[36:39], v1, s[20:23], s42 offen sc1
  v_lshlrev_b32 v12, 16, v40
  v_and_b32 v13, s38, v40
  v_lshlrev_b32 v14, 16, v41
  v_and_b32 v15, s38, v41
  v_lshlrev_b32 v16, 16, v42
  v_and_b32 v17, s38, v42
  v_lshlrev_b32 v18, 16, v43
  v_and_b32 v19, s38, v43
  v_pk_mul_f32 v[12:13], v[12:13], v[4:5]
  v_pk_mul_f32 v[14:15], v[14:15], v[6:7]
  v_pk_mul_f32 v[16:17], v[16:17], v[8:9]
  v_pk_mul_f32 v[18:19], v[18:19], v[10:11]
  v_cvt_pk_bf16_f32 v40, v12, v13
  v_cvt_pk_bf16_f32 v41, v14, v15
  v_cvt_pk_bf16_f32 v42, v16, v17
  v_cvt_pk_bf16_f32 v43, v18, v19
  s_add_u32 s42, s42, s43
  buffer_store_dwordx4 v[40:43], v1, s[20:23], s42 offen sc1
  v_lshlrev_b32 v12, 16, v128
  v_and_b32 v13, s38, v128
  v_lshlrev_b32 v14, 16, v129
  v_and_b32 v15, s38, v129
  v_lshlrev_b32 v16, 16, v130
  v_and_b32 v17, s38, v130
  v_lshlrev_b32 v18, 16, v131
  v_and_b32 v19, s38, v131
  v_pk_mul_f32 v[12:13], v[12:13], v[4:5]
  v_pk_mul_f32 v[14:15], v[14:15], v[6:7]
  v_pk_mul_f32 v[16:17], v[16:17], v[8:9]
  v_pk_mul_f32 v[18:19], v[18:19], v[10:11]
  v_cvt_pk_bf16_f32 v128, v12, v13
  v_cvt_pk_bf16_f32 v129, v14, v15
  v_cvt_pk_bf16_f32 v130, v16, v17
  v_cvt_pk_bf16_f32 v131, v18, v19
  buffer_store_dwordx4 v[128:131], v1, s[20:23], s65 offen sc1
  v_lshlrev_b32 v12, 16, v44
  v_and_b32 v13, s38, v44
  v_lshlrev_b32 v14, 16, v45
  v_and_b32 v15, s38, v45
  v_lshlrev_b32 v16, 16, v46
  v_and_b32 v17, s38, v46
  v_lshlrev_b32 v18, 16, v47
  v_and_b32 v19, s38, v47
  v_pk_mul_f32 v[12:13], v[12:13], v[4:5]
  v_pk_mul_f32 v[14:15], v[14:15], v[6:7]
  v_pk_mul_f32 v[16:17], v[16:17], v[8:9]
  v_pk_mul_f32 v[18:19], v[18:19], v[10:11]
  v_cvt_pk_bf16_f32 v44, v12, v13
  v_cvt_pk_bf16_f32 v45, v14, v15
  v_cvt_pk_bf16_f32 v46, v16, v17
  v_cvt_pk_bf16_f32 v47, v18, v19
  s_add_u32 s42, s42, s43
  buffer_store_dwordx4 v[44:47], v1, s[20:23], s42 offen sc1
  v_lshlrev_b32 v12, 16, v48
  v_and_b32 v13, s38, v48
  v_lshlrev_b32 v14, 16, v49
  v_and_b32 v15, s38, v49
  v_lshlrev_b32 v16, 16, v50
  v_and_b32 v17, s38, v50
  v_lshlrev_b32 v18, 16, v51
  v_and_b32 v19, s38, v51
  v_pk_mul_f32 v[12:13], v[12:13], v[4:5]
  v_pk_mul_f32 v[14:15], v[14:15], v[6:7]
  v_pk_mul_f32 v[16:17], v[16:17], v[8:9]
  v_pk_mul_f32 v[18:19], v[18:19], v[10:11]
  v_cvt_pk_bf16_f32 v48, v12, v13
  v_cvt_pk_bf16_f32 v49, v14, v15
  v_cvt_pk_bf16_f32 v50, v16, v17
  v_cvt_pk_bf16_f32 v51, v18, v19
  s_add_u32 s42, s42, s43
  buffer_store_dwordx4 v[48:51], v1, s[20:23], s42 offen sc1
  v_lshlrev_b32 v12, 16, v52
  v_and_b32 v13, s38, v52
  v_lshlrev_b32 v14, 16, v53
  v_and_b32 v15, s38, v53
  v_lshlrev_b32 v16, 16, v54
  v_and_b32 v17, s38, v54
  v_lshlrev_b32 v18, 16, v55
  v_and_b32 v19, s38, v55
  v_pk_mul_f32 v[12:13], v[12:13], v[4:5]
  v_pk_mul_f32 v[14:15], v[14:15], v[6:7]
  v_pk_mul_f32 v[16:17], v[16:17], v[8:9]
  v_pk_mul_f32 v[18:19], v[18:19], v[10:11]
  v_cvt_pk_bf16_f32 v52, v12, v13
  v_cvt_pk_bf16_f32 v53, v14, v15
  v_cvt_pk_bf16_f32 v54, v16, v17
  v_cvt_pk_bf16_f32 v55, v18, v19
  s_add_u32 s42, s42, s43
  buffer_store_dwordx4 v[52:55], v1, s[20:23], s42 offen sc1
  v_lshlrev_b32 v12, 16, v56
  v_and_b32 v13, s38, v56
  v_lshlrev_b32 v14, 16, v57
  v_and_b32 v15, s38, v57
  v_lshlrev_b32 v16, 16, v58
  v_and_b32 v17, s38, v58
  v_lshlrev_b32 v18, 16, v59
  v_and_b32 v19, s38, v59
  v_pk_mul_f32 v[12:13], v[12:13], v[4:5]
  v_pk_mul_f32 v[14:15], v[14:15], v[6:7]
  v_pk_mul_f32 v[16:17], v[16:17], v[8:9]
  v_pk_mul_f32 v[18:19], v[18:19], v[10:11]
  v_cvt_pk_bf16_f32 v56, v12, v13
  v_cvt_pk_bf16_f32 v57, v14, v15
  v_cvt_pk_bf16_f32 v58, v16, v17
  v_cvt_pk_bf16_f32 v59, v18, v19
  s_add_u32 s42, s42, s43
  buffer_store_dwordx4 v[56:59], v1, s[20:23], s42 offen sc1
  v_lshlrev_b32 v12, 16, v132
  v_and_b32 v13, s38, v132
  v_lshlrev_b32 v14, 16, v133
  v_and_b32 v15, s38, v133
  v_lshlrev_b32 v16, 16, v134
  v_and_b32 v17, s38, v134
  v_lshlrev_b32 v18, 16, v135
  v_and_b32 v19, s38, v135
  v_pk_mul_f32 v[12:13], v[12:13], v[4:5]
  v_pk_mul_f32 v[14:15], v[14:15], v[6:7]
  v_pk_mul_f32 v[16:17], v[16:17], v[8:9]
  v_pk_mul_f32 v[18:19], v[18:19], v[10:11]
  v_cvt_pk_bf16_f32 v132, v12, v13
  v_cvt_pk_bf16_f32 v133, v14, v15
  v_cvt_pk_bf16_f32 v134, v16, v17
  v_cvt_pk_bf16_f32 v135, v18, v19
  buffer_store_dwordx4 v[132:135], v1, s[20:23], s66 offen sc1
  v_lshlrev_b32 v12, 16, v60
  v_and_b32 v13, s38, v60
  v_lshlrev_b32 v14, 16, v61
  v_and_b32 v15, s38, v61
  v_lshlrev_b32 v16, 16, v62
  v_and_b32 v17, s38, v62
  v_lshlrev_b32 v18, 16, v63
  v_and_b32 v19, s38, v63
  v_pk_mul_f32 v[12:13], v[12:13], v[4:5]
  v_pk_mul_f32 v[14:15], v[14:15], v[6:7]
  v_pk_mul_f32 v[16:17], v[16:17], v[8:9]
  v_pk_mul_f32 v[18:19], v[18:19], v[10:11]
  v_cvt_pk_bf16_f32 v60, v12, v13
  v_cvt_pk_bf16_f32 v61, v14, v15
  v_cvt_pk_bf16_f32 v62, v16, v17
  v_cvt_pk_bf16_f32 v63, v18, v19
  s_add_u32 s42, s42, s43
  buffer_store_dwordx4 v[60:63], v1, s[20:23], s42 offen sc1
  v_lshlrev_b32 v12, 16, v64
  v_and_b32 v13, s38, v64
  v_lshlrev_b32 v14, 16, v65
  v_and_b32 v15, s38, v65
  v_lshlrev_b32 v16, 16, v66
  v_and_b32 v17, s38, v66
  v_lshlrev_b32 v18, 16, v67
  v_and_b32 v19, s38, v67
  v_pk_mul_f32 v[12:13], v[12:13], v[4:5]
  v_pk_mul_f32 v[14:15], v[14:15], v[6:7]
  v_pk_mul_f32 v[16:17], v[16:17], v[8:9]
  v_pk_mul_f32 v[18:19], v[18:19], v[10:11]
  v_cvt_pk_bf16_f32 v64, v12, v13
  v_cvt_pk_bf16_f32 v65, v14, v15
  v_cvt_pk_bf16_f32 v66, v16, v17
  v_cvt_pk_bf16_f32 v67, v18, v19
  s_add_u32 s42, s42, s43
  buffer_store_dwordx4 v[64:67], v1, s[20:23], s42 offen sc1
  v_lshlrev_b32 v12, 16, v68
  v_and_b32 v13, s38, v68
  v_lshlrev_b32 v14, 16, v69
  v_and_b32 v15, s38, v69
  v_lshlrev_b32 v16, 16, v70
  v_and_b32 v17, s38, v70
  v_lshlrev_b32 v18, 16, v71
  v_and_b32 v19, s38, v71
  v_pk_mul_f32 v[12:13], v[12:13], v[4:5]
  v_pk_mul_f32 v[14:15], v[14:15], v[6:7]
  v_pk_mul_f32 v[16:17], v[16:17], v[8:9]
  v_pk_mul_f32 v[18:19], v[18:19], v[10:11]
  v_cvt_pk_bf16_f32 v68, v12, v13
  v_cvt_pk_bf16_f32 v69, v14, v15
  v_cvt_pk_bf16_f32 v70, v16, v17
  v_cvt_pk_bf16_f32 v71, v18, v19
  s_add_u32 s42, s42, s43
  buffer_store_dwordx4 v[68:71], v1, s[20:23], s42 offen sc1
  v_lshlrev_b32 v12, 16, v72
  v_and_b32 v13, s38, v72
  v_lshlrev_b32 v14, 16, v73
  v_and_b32 v15, s38, v73
  v_lshlrev_b32 v16, 16, v74
  v_and_b32 v17, s38, v74
  v_lshlrev_b32 v18, 16, v75
  v_and_b32 v19, s38, v75
  v_pk_mul_f32 v[12:13], v[12:13], v[4:5]
  v_pk_mul_f32 v[14:15], v[14:15], v[6:7]
  v_pk_mul_f32 v[16:17], v[16:17], v[8:9]
  v_pk_mul_f32 v[18:19], v[18:19], v[10:11]
  v_cvt_pk_bf16_f32 v72, v12, v13
  v_cvt_pk_bf16_f32 v73, v14, v15
  v_cvt_pk_bf16_f32 v74, v16, v17
  v_cvt_pk_bf16_f32 v75, v18, v19
  s_add_u32 s42, s42, s43
  buffer_store_dwordx4 v[72:75], v1, s[20:23], s42 offen sc1
  v_lshlrev_b32 v12, 16, v76
  v_and_b32 v13, s38, v76
  v_lshlrev_b32 v14, 16, v77
  v_and_b32 v15, s38, v77
  v_lshlrev_b32 v16, 16, v78
  v_and_b32 v17, s38, v78
  v_lshlrev_b32 v18, 16, v79
  v_and_b32 v19, s38, v79
  v_pk_mul_f32 v[12:13], v[12:13], v[4:5]
  v_pk_mul_f32 v[14:15], v[14:15], v[6:7]
  v_pk_mul_f32 v[16:17], v[16:17], v[8:9]
  v_pk_mul_f32 v[18:19], v[18:19], v[10:11]
  v_cvt_pk_bf16_f32 v76, v12, v13
  v_cvt_pk_bf16_f32 v77, v14, v15
  v_cvt_pk_bf16_f32 v78, v16, v17
  v_cvt_pk_bf16_f32 v79, v18, v19
  s_add_u32 s42, s42, s43
  buffer_store_dwordx4 v[76:79], v1, s[20:23], s42 offen sc1
  v_lshlrev_b32 v12, 16, v136
  v_and_b32 v13, s38, v136
  v_lshlrev_b32 v14, 16, v137
  v_and_b32 v15, s38, v137
  v_lshlrev_b32 v16, 16, v138
  v_and_b32 v17, s38, v138
  v_lshlrev_b32 v18, 16, v139
  v_and_b32 v19, s38, v139
  v_pk_mul_f32 v[12:13], v[12:13], v[4:5]
  v_pk_mul_f32 v[14:15], v[14:15], v[6:7]
  v_pk_mul_f32 v[16:17], v[16:17], v[8:9]
  v_pk_mul_f32 v[18:19], v[18:19], v[10:11]
  v_cvt_pk_bf16_f32 v136, v12, v13
  v_cvt_pk_bf16_f32 v137, v14, v15
  v_cvt_pk_bf16_f32 v138, v16, v17
  v_cvt_pk_bf16_f32 v139, v18, v19
  buffer_store_dwordx4 v[136:139], v1, s[20:23], s67 offen sc1
  v_lshlrev_b32 v12, 16, v80
  v_and_b32 v13, s38, v80
  v_lshlrev_b32 v14, 16, v81
  v_and_b32 v15, s38, v81
  v_lshlrev_b32 v16, 16, v82
  v_and_b32 v17, s38, v82
  v_lshlrev_b32 v18, 16, v83
  v_and_b32 v19, s38, v83
  v_pk_mul_f32 v[12:13], v[12:13], v[4:5]
  v_pk_mul_f32 v[14:15], v[14:15], v[6:7]
  v_pk_mul_f32 v[16:17], v[16:17], v[8:9]
  v_pk_mul_f32 v[18:19], v[18:19], v[10:11]
  v_cvt_pk_bf16_f32 v80, v12, v13
  v_cvt_pk_bf16_f32 v81, v14, v15
  v_cvt_pk_bf16_f32 v82, v16, v17
  v_cvt_pk_bf16_f32 v83, v18, v19
  s_add_u32 s42, s42, s43
  buffer_store_dwordx4 v[80:83], v1, s[20:23], s42 offen sc1
  v_lshlrev_b32 v12, 16, v84
  v_and_b32 v13, s38, v84
  v_lshlrev_b32 v14, 16, v85
  v_and_b32 v15, s38, v85
  v_lshlrev_b32 v16, 16, v86
  v_and_b32 v17, s38, v86
  v_lshlrev_b32 v18, 16, v87
  v_and_b32 v19, s38, v87
  v_pk_mul_f32 v[12:13], v[12:13], v[4:5]
  v_pk_mul_f32 v[14:15], v[14:15], v[6:7]
  v_pk_mul_f32 v[16:17], v[16:17], v[8:9]
  v_pk_mul_f32 v[18:19], v[18:19], v[10:11]
  v_cvt_pk_bf16_f32 v84, v12, v13
  v_cvt_pk_bf16_f32 v85, v14, v15
  v_cvt_pk_bf16_f32 v86, v16, v17
  v_cvt_pk_bf16_f32 v87, v18, v19
  s_add_u32 s42, s42, s43
  buffer_store_dwordx4 v[84:87], v1, s[20:23], s42 offen sc1
  v_lshlrev_b32 v12, 16, v88
  v_and_b32 v13, s38, v88
  v_lshlrev_b32 v14, 16, v89
  v_and_b32 v15, s38, v89
  v_lshlrev_b32 v16, 16, v90
  v_and_b32 v17, s38, v90
  v_lshlrev_b32 v18, 16, v91
  v_and_b32 v19, s38, v91
  v_pk_mul_f32 v[12:13], v[12:13], v[4:5]
  v_pk_mul_f32 v[14:15], v[14:15], v[6:7]
  v_pk_mul_f32 v[16:17], v[16:17], v[8:9]
  v_pk_mul_f32 v[18:19], v[18:19], v[10:11]
  v_cvt_pk_bf16_f32 v88, v12, v13
  v_cvt_pk_bf16_f32 v89, v14, v15
  v_cvt_pk_bf16_f32 v90, v16, v17
  v_cvt_pk_bf16_f32 v91, v18, v19
  s_add_u32 s42, s42, s43
  buffer_store_dwordx4 v[88:91], v1, s[20:23], s42 offen sc1
  v_lshlrev_b32 v12, 16, v92
  v_and_b32 v13, s38, v92
  v_lshlrev_b32 v14, 16, v93
  v_and_b32 v15, s38, v93
  v_lshlrev_b32 v16, 16, v94
  v_and_b32 v17, s38, v94
  v_lshlrev_b32 v18, 16, v95
  v_and_b32 v19, s38, v95
  v_pk_mul_f32 v[12:13], v[12:13], v[4:5]
  v_pk_mul_f32 v[14:15], v[14:15], v[6:7]
  v_pk_mul_f32 v[16:17], v[16:17], v[8:9]
  v_pk_mul_f32 v[18:19], v[18:19], v[10:11]
  v_cvt_pk_bf16_f32 v92, v12, v13
  v_cvt_pk_bf16_f32 v93, v14, v15
  v_cvt_pk_bf16_f32 v94, v16, v17
  v_cvt_pk_bf16_f32 v95, v18, v19
  s_add_u32 s42, s42, s43
  buffer_store_dwordx4 v[92:95], v1, s[20:23], s42 offen sc1
  v_lshlrev_b32 v12, 16, v140
  v_and_b32 v13, s38, v140
  v_lshlrev_b32 v14, 16, v141
  v_and_b32 v15, s38, v141
  v_lshlrev_b32 v16, 16, v142
  v_and_b32 v17, s38, v142
  v_lshlrev_b32 v18, 16, v143
  v_and_b32 v19, s38, v143
  v_pk_mul_f32 v[12:13], v[12:13], v[4:5]
  v_pk_mul_f32 v[14:15], v[14:15], v[6:7]
  v_pk_mul_f32 v[16:17], v[16:17], v[8:9]
  v_pk_mul_f32 v[18:19], v[18:19], v[10:11]
  v_cvt_pk_bf16_f32 v140, v12, v13
  v_cvt_pk_bf16_f32 v141, v14, v15
  v_cvt_pk_bf16_f32 v142, v16, v17
  v_cvt_pk_bf16_f32 v143, v18, v19
  buffer_store_dwordx4 v[140:143], v1, s[20:23], s68 offen sc1
  v_lshlrev_b32 v12, 16, v96
  v_and_b32 v13, s38, v96
  v_lshlrev_b32 v14, 16, v97
  v_and_b32 v15, s38, v97
  v_lshlrev_b32 v16, 16, v98
  v_and_b32 v17, s38, v98
  v_lshlrev_b32 v18, 16, v99
  v_and_b32 v19, s38, v99
  v_pk_mul_f32 v[12:13], v[12:13], v[4:5]
  v_pk_mul_f32 v[14:15], v[14:15], v[6:7]
  v_pk_mul_f32 v[16:17], v[16:17], v[8:9]
  v_pk_mul_f32 v[18:19], v[18:19], v[10:11]
  v_cvt_pk_bf16_f32 v96, v12, v13
  v_cvt_pk_bf16_f32 v97, v14, v15
  v_cvt_pk_bf16_f32 v98, v16, v17
  v_cvt_pk_bf16_f32 v99, v18, v19
  s_add_u32 s42, s42, s43
  buffer_store_dwordx4 v[96:99], v1, s[20:23], s42 offen sc1
  v_lshlrev_b32 v12, 16, v100
  v_and_b32 v13, s38, v100
  v_lshlrev_b32 v14, 16, v101
  v_and_b32 v15, s38, v101
  v_lshlrev_b32 v16, 16, v102
  v_and_b32 v17, s38, v102
  v_lshlrev_b32 v18, 16, v103
  v_and_b32 v19, s38, v103
  v_pk_mul_f32 v[12:13], v[12:13], v[4:5]
  v_pk_mul_f32 v[14:15], v[14:15], v[6:7]
  v_pk_mul_f32 v[16:17], v[16:17], v[8:9]
  v_pk_mul_f32 v[18:19], v[18:19], v[10:11]
  v_cvt_pk_bf16_f32 v100, v12, v13
  v_cvt_pk_bf16_f32 v101, v14, v15
  v_cvt_pk_bf16_f32 v102, v16, v17
  v_cvt_pk_bf16_f32 v103, v18, v19
  s_add_u32 s42, s42, s43
  buffer_store_dwordx4 v[100:103], v1, s[20:23], s42 offen sc1
  v_lshlrev_b32 v12, 16, v104
  v_and_b32 v13, s38, v104
  v_lshlrev_b32 v14, 16, v105
  v_and_b32 v15, s38, v105
  v_lshlrev_b32 v16, 16, v106
  v_and_b32 v17, s38, v106
  v_lshlrev_b32 v18, 16, v107
  v_and_b32 v19, s38, v107
  v_pk_mul_f32 v[12:13], v[12:13], v[4:5]
  v_pk_mul_f32 v[14:15], v[14:15], v[6:7]
  v_pk_mul_f32 v[16:17], v[16:17], v[8:9]
  v_pk_mul_f32 v[18:19], v[18:19], v[10:11]
  v_cvt_pk_bf16_f32 v104, v12, v13
  v_cvt_pk_bf16_f32 v105, v14, v15
  v_cvt_pk_bf16_f32 v106, v16, v17
  v_cvt_pk_bf16_f32 v107, v18, v19
  s_add_u32 s42, s42, s43
  buffer_store_dwordx4 v[104:107], v1, s[20:23], s42 offen sc1
  v_lshlrev_b32 v12, 16, v108
  v_and_b32 v13, s38, v108
  v_lshlrev_b32 v14, 16, v109
  v_and_b32 v15, s38, v109
  v_lshlrev_b32 v16, 16, v110
  v_and_b32 v17, s38, v110
  v_lshlrev_b32 v18, 16, v111
  v_and_b32 v19, s38, v111
  v_pk_mul_f32 v[12:13], v[12:13], v[4:5]
  v_pk_mul_f32 v[14:15], v[14:15], v[6:7]
  v_pk_mul_f32 v[16:17], v[16:17], v[8:9]
  v_pk_mul_f32 v[18:19], v[18:19], v[10:11]
  v_cvt_pk_bf16_f32 v108, v12, v13
  v_cvt_pk_bf16_f32 v109, v14, v15
  v_cvt_pk_bf16_f32 v110, v16, v17
  v_cvt_pk_bf16_f32 v111, v18, v19
  s_add_u32 s42, s42, s43
  buffer_store_dwordx4 v[108:111], v1, s[20:23], s42 offen sc1
  v_lshlrev_b32 v12, 16, v144
  v_and_b32 v13, s38, v144
  v_lshlrev_b32 v14, 16, v145
  v_and_b32 v15, s38, v145
  v_lshlrev_b32 v16, 16, v146
  v_and_b32 v17, s38, v146
  v_lshlrev_b32 v18, 16, v147
  v_and_b32 v19, s38, v147
  v_pk_mul_f32 v[12:13], v[12:13], v[4:5]
  v_pk_mul_f32 v[14:15], v[14:15], v[6:7]
  v_pk_mul_f32 v[16:17], v[16:17], v[8:9]
  v_pk_mul_f32 v[18:19], v[18:19], v[10:11]
  v_cvt_pk_bf16_f32 v144, v12, v13
  v_cvt_pk_bf16_f32 v145, v14, v15
  v_cvt_pk_bf16_f32 v146, v16, v17
  v_cvt_pk_bf16_f32 v147, v18, v19
  buffer_store_dwordx4 v[144:147], v1, s[20:23], s69 offen sc1
  v_lshlrev_b32 v12, 16, v112
  v_and_b32 v13, s38, v112
  v_lshlrev_b32 v14, 16, v113
  v_and_b32 v15, s38, v113
  v_lshlrev_b32 v16, 16, v114
  v_and_b32 v17, s38, v114
  v_lshlrev_b32 v18, 16, v115
  v_and_b32 v19, s38, v115
  v_pk_mul_f32 v[12:13], v[12:13], v[4:5]
  v_pk_mul_f32 v[14:15], v[14:15], v[6:7]
  v_pk_mul_f32 v[16:17], v[16:17], v[8:9]
  v_pk_mul_f32 v[18:19], v[18:19], v[10:11]
  v_cvt_pk_bf16_f32 v112, v12, v13
  v_cvt_pk_bf16_f32 v113, v14, v15
  v_cvt_pk_bf16_f32 v114, v16, v17
  v_cvt_pk_bf16_f32 v115, v18, v19
  s_add_u32 s42, s42, s43
  buffer_store_dwordx4 v[112:115], v1, s[20:23], s42 offen sc1
  v_lshlrev_b32 v12, 16, v116
  v_and_b32 v13, s38, v116
  v_lshlrev_b32 v14, 16, v117
  v_and_b32 v15, s38, v117
  v_lshlrev_b32 v16, 16, v118
  v_and_b32 v17, s38, v118
  v_lshlrev_b32 v18, 16, v119
  v_and_b32 v19, s38, v119
  v_pk_mul_f32 v[12:13], v[12:13], v[4:5]
  v_pk_mul_f32 v[14:15], v[14:15], v[6:7]
  v_pk_mul_f32 v[16:17], v[16:17], v[8:9]
  v_pk_mul_f32 v[18:19], v[18:19], v[10:11]
  v_cvt_pk_bf16_f32 v116, v12, v13
  v_cvt_pk_bf16_f32 v117, v14, v15
  v_cvt_pk_bf16_f32 v118, v16, v17
  v_cvt_pk_bf16_f32 v119, v18, v19
  s_add_u32 s42, s42, s43
  buffer_store_dwordx4 v[116:119], v1, s[20:23], s42 offen sc1
  v_lshlrev_b32 v12, 16, v120
  v_and_b32 v13, s38, v120
  v_lshlrev_b32 v14, 16, v121
  v_and_b32 v15, s38, v121
  v_lshlrev_b32 v16, 16, v122
  v_and_b32 v17, s38, v122
  v_lshlrev_b32 v18, 16, v123
  v_and_b32 v19, s38, v123
  v_pk_mul_f32 v[12:13], v[12:13], v[4:5]
  v_pk_mul_f32 v[14:15], v[14:15], v[6:7]
  v_pk_mul_f32 v[16:17], v[16:17], v[8:9]
  v_pk_mul_f32 v[18:19], v[18:19], v[10:11]
  v_cvt_pk_bf16_f32 v120, v12, v13
  v_cvt_pk_bf16_f32 v121, v14, v15
  v_cvt_pk_bf16_f32 v122, v16, v17
  v_cvt_pk_bf16_f32 v123, v18, v19
  s_add_u32 s42, s42, s43
  buffer_store_dwordx4 v[120:123], v1, s[20:23], s42 offen sc1
L_end:
  s_endpgm
.section .rodata,"a"
.p2align 6
.amdhsa_kernel standalone__channel_attn_eca__vision_kernel
  .amdhsa_next_free_vgpr 152
  .amdhsa_next_free_sgpr 96
  .amdhsa_accum_offset 152
  .amdhsa_group_segment_fixed_size 0
  .amdhsa_kernarg_size 40
  .amdhsa_user_sgpr_count 2
  .amdhsa_user_sgpr_kernarg_segment_ptr 1
  .amdhsa_system_sgpr_workgroup_id_x 1
  .amdhsa_float_denorm_mode_32 3
.end_amdhsa_kernel
```
